```python
import torch

def _softmax(x, axis=-1):
    return torch.softmax(x, dim=axis)
def _gelu(x):
    return torch.nn.functional.gelu(x, approximate="tanh")
def _silu(x):
    return torch.nn.functional.silu(x)
def _sigmoid(x):
    return torch.sigmoid(x)
def _layernorm(x, axis=-1, eps=1e-5):
    m = x.mean(dim=axis, keepdim=True)
    v = x.var(dim=axis, keepdim=True, unbiased=False)
    return (x - m) / torch.sqrt(v + eps)
def _scatter_add(tgt, idx, src, axis=0):
    return tgt.clone().index_add_(axis, idx, src)
def _segment_sum(src, seg, n):
    out = torch.zeros((n,) + src.shape[1:], dtype=src.dtype)
    return out.index_add_(0, seg, src)
def _pad(x, pw):
    flat = tuple(v for pair in reversed(pw) for v in pair)
    return torch.nn.functional.pad(x, flat)

kernel_name = 'standalone__gqa_softmax__sampling'

def setup_inputs():

    _w = (lambda a: (lambda t: t.to(torch.bfloat16) if t.is_floating_point() else t)(torch.as_tensor(a)))
    B, Hq, Hkv, Sq, Sk, D = 8, 32, 8, 8, 2048, 128
    return {
        "q": _w((lambda *s: torch.randn(*s, dtype=torch.bfloat16) * 0.8)(B, Hq, Sq, D)),
        "k": _w((lambda *s: torch.randn(*s, dtype=torch.bfloat16) * 0.8)(B, Hkv, Sk, D)),
        "v": _w((lambda *s: torch.randn(*s, dtype=torch.bfloat16) * 0.05)(B, Hkv, Sk, D)),
    }

def reference(q, k, v):
    B, Hq, Sq, D = q.shape
    Hkv = k.shape[1]
    rep = Hq // Hkv
    k = (lambda x, n, axis: torch.repeat_interleave(x, n, dim=axis))(k, rep, axis=1)
    v = (lambda x, n, axis: torch.repeat_interleave(x, n, dim=axis))(v, rep, axis=1)
    scale = D ** -0.5
    scores = torch.einsum("bhqd,bhkd->bhqk", q, k) * scale
    p = _softmax(scores, axis=-1)
    return torch.einsum("bhqk,bhkd->bhqd", p, v)
```

```asm
; @launch grid=(256,1,1) block=(320,1,1) lds=163840
.amdgcn_target "amdgcn-amd-amdhsa--gfx950"
.text
.globl standalone__gqa_softmax__sampling_kernel
.p2align 8
.type standalone__gqa_softmax__sampling_kernel,@function
standalone__gqa_softmax__sampling_kernel:
s_load_dwordx4 s[4:7], s[0:1], 0
s_load_dwordx4 s[8:11], s[0:1], 16
v_lshrrev_b32 v7, 6, v0
s_cmp_ge_u32 s2, 256
s_cbranch_scc1 L_end
v_readfirstlane_b32 s3, v7
v_and_b32 v1, 63, v0
s_and_b32 s39, s2, 7
s_lshl_b32 s39, s39, 5
s_lshr_b32 s40, s2, 3
s_add_u32 s39, s39, s40
s_lshr_b32 s28, s39, 2
v_mov_b32 v31, 126976
s_cmp_eq_u32 s3, 4
s_cbranch_scc0 L_compute
v_lshrrev_b32 v8, 4, v1
v_and_b32 v9, 15, v1
s_lshl_b32 s30, s39, 17
v_xor_b32 v10, v9, v8
v_lshlrev_b32 v11, 8, v8
s_lshl_b32 s39, s28, 13
v_lshl_add_u32 v2, v10, 4, v11
s_mov_b32 m0, 131072
s_mov_b32 s43, s30
s_mov_b32 s14, 0x80000
s_mov_b32 s15, 0x20000
v_xor_b32 v3, 64, v2
v_xor_b32 v4, 0x80, v2
v_xor_b32 v5, 0xc0, v2
s_mov_b32 s18, 0x2000000
s_mov_b32 s19, 0x20000
s_add_u32 s40, s39, 0x1000
s_waitcnt lgkmcnt(0)
s_mov_b32 s16, s6
s_mov_b32 s17, s7
s_mov_b32 s12, s4
s_mov_b32 s13, s5
buffer_load_dwordx4 v2, s[12:15], s39 offen offset:0  lds
buffer_load_dwordx4 v3, s[12:15], s39 offen offset:1024  lds
buffer_load_dwordx4 v4, s[12:15], s39 offen offset:2048  lds
buffer_load_dwordx4 v5, s[12:15], s39 offen offset:3072  lds
s_mov_b32 m0, 135168
s_nop 0
buffer_load_dwordx4 v2, s[12:15], s40 offen offset:0  lds
buffer_load_dwordx4 v3, s[12:15], s40 offen offset:1024  lds
buffer_load_dwordx4 v4, s[12:15], s40 offen offset:2048  lds
buffer_load_dwordx4 v5, s[12:15], s40 offen offset:3072  lds
s_mov_b32 m0, 0
s_nop 0
buffer_load_dwordx4 v2, s[16:19], s30 offen offset:0 nt lds
buffer_load_dwordx4 v3, s[16:19], s30 offen offset:1024 nt lds
buffer_load_dwordx4 v4, s[16:19], s30 offen offset:2048 nt lds
buffer_load_dwordx4 v5, s[16:19], s30 offen offset:3072 nt lds
s_add_u32 m0, m0, 0x1000
s_add_u32 s30, s30, 0x1000
buffer_load_dwordx4 v2, s[16:19], s30 offen offset:0 nt lds
buffer_load_dwordx4 v3, s[16:19], s30 offen offset:1024 nt lds
buffer_load_dwordx4 v4, s[16:19], s30 offen offset:2048 nt lds
buffer_load_dwordx4 v5, s[16:19], s30 offen offset:3072 nt lds
s_add_u32 m0, m0, 0x1000
s_add_u32 s30, s30, 0x1000
s_load_dword s44, s[8:9], s43
s_setprio 3
v_lshlrev_b32 v10, 2, v8
v_xor_b32 v10, v9, v10
v_lshl_add_u32 v6, v10, 4, v11
s_mov_b32 s20, s8
s_mov_b32 s21, s9
s_mov_b32 s22, 0x2000000
s_mov_b32 s23, 0x20000
buffer_load_dwordx4 v2, s[16:19], s30 offen offset:0 nt lds
buffer_load_dwordx4 v3, s[16:19], s30 offen offset:1024 nt lds
buffer_load_dwordx4 v4, s[16:19], s30 offen offset:2048 nt lds
buffer_load_dwordx4 v5, s[16:19], s30 offen offset:3072 nt lds
s_add_u32 m0, m0, 0x1000
s_add_u32 s30, s30, 0x1000
buffer_load_dwordx4 v2, s[16:19], s30 offen offset:0 nt lds
buffer_load_dwordx4 v3, s[16:19], s30 offen offset:1024 nt lds
buffer_load_dwordx4 v4, s[16:19], s30 offen offset:2048 nt lds
buffer_load_dwordx4 v5, s[16:19], s30 offen offset:3072 nt lds
s_add_u32 m0, m0, 0x1000
s_add_u32 s30, s30, 0x1000
v_mov_b32 v27, -16
s_mov_b32 s42, 13
s_barrier
L_kloop:
buffer_load_dwordx4 v2, s[16:19], s30 offen offset:0 nt lds
buffer_load_dwordx4 v3, s[16:19], s30 offen offset:1024 nt lds
buffer_load_dwordx4 v4, s[16:19], s30 offen offset:2048 nt lds
buffer_load_dwordx4 v5, s[16:19], s30 offen offset:3072 nt lds
s_add_u32 m0, m0, 0x1000
s_add_u32 s30, s30, 0x1000
buffer_load_dwordx4 v2, s[16:19], s30 offen offset:0 nt lds
buffer_load_dwordx4 v3, s[16:19], s30 offen offset:1024 nt lds
buffer_load_dwordx4 v4, s[16:19], s30 offen offset:2048 nt lds
buffer_load_dwordx4 v5, s[16:19], s30 offen offset:3072 nt lds
s_add_u32 m0, m0, 0x1000
s_add_u32 s30, s30, 0x1000
s_sub_u32 s42, s42, 1
v_add_u32 v27, 8, v27
s_waitcnt vmcnt(40)
ds_write_b32 v31, v27
s_cmp_lg_u32 s42, 0
s_cbranch_scc1 L_kloop
s_mov_b32 m0, 139264
s_nop 0
buffer_load_dwordx4 v2, s[16:19], s30 offen offset:0 nt lds
buffer_load_dwordx4 v3, s[16:19], s30 offen offset:1024 nt lds
buffer_load_dwordx4 v4, s[16:19], s30 offen offset:2048 nt lds
buffer_load_dwordx4 v5, s[16:19], s30 offen offset:3072 nt lds
s_add_u32 m0, m0, 0x1000
s_add_u32 s30, s30, 0x1000
buffer_load_dwordx4 v2, s[16:19], s30 offen offset:0 nt lds
buffer_load_dwordx4 v3, s[16:19], s30 offen offset:1024 nt lds
buffer_load_dwordx4 v4, s[16:19], s30 offen offset:2048 nt lds
buffer_load_dwordx4 v5, s[16:19], s30 offen offset:3072 nt lds
s_add_u32 m0, m0, 0x1000
s_add_u32 s30, s30, 0x1000
v_add_u32 v27, 8, v27
s_waitcnt vmcnt(40)
ds_write_b32 v31, v27
s_mov_b32 m0, 0
s_mov_b32 s40, 1
L_vsec:
ds_read_b128 v[8:11], v31 offset:16
s_waitcnt lgkmcnt(0)
v_min3_u32 v8, v8, v9, v10
v_min_u32 v8, v8, v11
s_nop 0
v_readfirstlane_b32 s39, v8
s_cmp_ge_u32 s39, s40
s_cbranch_scc0 L_vsec
s_cmp_eq_u32 s40, 4
s_cselect_b32 s42, 7, 8
L_vloop:
buffer_load_dwordx4 v6, s[20:23], s43 offen offset:0 nt lds
buffer_load_dwordx4 v6, s[20:23], s43 offen offset:1024 nt lds
buffer_load_dwordx4 v6, s[20:23], s43 offen offset:2048 nt lds
buffer_load_dwordx4 v6, s[20:23], s43 offen offset:3072 nt lds
s_add_u32 m0, m0, 0x1000
s_add_u32 s43, s43, 0x1000
s_sub_u32 s42, s42, 1
v_add_u32 v27, 4, v27
s_waitcnt vmcnt(40)
ds_write_b32 v31, v27
s_cmp_lg_u32 s42, 0
s_cbranch_scc1 L_vloop
s_add_u32 s40, s40, 1
s_cmp_le_u32 s40, 4
s_cbranch_scc1 L_vsec
L_vchk:
ds_read_b32 v8, v31 offset:40
s_waitcnt lgkmcnt(0)
v_readfirstlane_b32 s39, v8
s_cmp_ge_u32 s39, 4
s_cbranch_scc0 L_vchk
s_mov_b32 m0, 131072
s_nop 0
buffer_load_dwordx4 v6, s[20:23], s43 offen offset:0 nt lds
buffer_load_dwordx4 v6, s[20:23], s43 offen offset:1024 nt lds
buffer_load_dwordx4 v6, s[20:23], s43 offen offset:2048 nt lds
buffer_load_dwordx4 v6, s[20:23], s43 offen offset:3072 nt lds
s_add_u32 m0, m0, 0x1000
s_add_u32 s43, s43, 0x1000
v_add_u32 v27, 4, v27
s_waitcnt vmcnt(40)
ds_write_b32 v31, v27
v_add_u32 v27, 4, v27
s_waitcnt vmcnt(36)
ds_write_b32 v31, v27
v_add_u32 v27, 4, v27
s_waitcnt vmcnt(32)
ds_write_b32 v31, v27
v_add_u32 v27, 4, v27
s_waitcnt vmcnt(28)
ds_write_b32 v31, v27
v_add_u32 v27, 4, v27
s_waitcnt vmcnt(24)
ds_write_b32 v31, v27
v_add_u32 v27, 4, v27
s_waitcnt vmcnt(20)
ds_write_b32 v31, v27
v_add_u32 v27, 4, v27
s_waitcnt vmcnt(16)
ds_write_b32 v31, v27
v_add_u32 v27, 4, v27
s_waitcnt vmcnt(12)
ds_write_b32 v31, v27
v_add_u32 v27, 4, v27
s_waitcnt vmcnt(8)
ds_write_b32 v31, v27
s_waitcnt vmcnt(4)
s_barrier
s_waitcnt vmcnt(0)
s_barrier
s_endpgm
L_compute:
s_load_dwordx2 s[22:23], s[0:1], 40
v_mov_b32 v8, 0
v_lshl_add_u32 v9, v1, 2, v31
ds_write_b32 v9, v8 offset:0
s_and_b32 s29, s39, 3
s_lshl_b32 s38, s28, 16
s_getpc_b64 s[74:75]
L_pc:
s_lshr_b32 s39, s2, 3
s_lshl_b32 s39, s39, 2
s_add_u32 s39, s39, s3
s_lshl_b32 s39, s39, 6
s_min_u32 s39, s39, L_codeend-L_pc-4
s_waitcnt lgkmcnt(0)
s_load_dword s37, s[22:23], s38
s_load_dword s44, s[74:75], s39
s_barrier
v_mov_b32 v200, 1
s_mov_b32 s31, 0
s_mov_b32 s36, 0x3e0293ee
s_mov_b32 s26, 0x10000000
s_mov_b32 s27, 0x20000
s_mov_b32 s34, 0x80000
s_mov_b32 s35, 0x20000
s_getreg_b32 s47, hwreg(HW_REG_XCC_ID, 0, 4)
s_mov_b32 s24, s22
s_mov_b32 s25, s23
s_mov_b32 s32, s10
s_mov_b32 s33, s11
s_lshl_b32 s39, s28, 16
s_lshl_b32 s40, s3, 12
s_add_u32 s39, s39, s40
s_lshl_b32 s40, s29, 14
s_add_u32 s41, s39, s40
s_xor_b32 s40, s29, 1
s_lshl_b32 s40, s40, 14
s_add_u32 s65, s39, s40
s_xor_b32 s40, s29, 2
s_lshl_b32 s40, s40, 14
s_add_u32 s66, s39, s40
s_xor_b32 s40, s29, 3
s_lshl_b32 s40, s40, 14
s_add_u32 s67, s39, s40
s_add_u32 s39, s38, 0x1000
s_xor_b32 s40, s29, 0
s_lshl_b32 s40, s40, 14
s_add_u32 s68, s39, s40
s_xor_b32 s40, s29, 1
s_lshl_b32 s40, s40, 14
s_add_u32 s69, s39, s40
s_xor_b32 s40, s29, 2
s_lshl_b32 s40, s40, 14
s_add_u32 s70, s39, s40
s_xor_b32 s40, s29, 3
s_lshl_b32 s40, s40, 14
s_add_u32 s71, s39, s40
s_lshl_b32 s40, s3, 7
s_add_u32 s40, s40, s68
s_load_dword s73, s[22:23], s40
s_lshl_b32 s16, s28, 13
s_lshl_b32 s40, s3, 6
s_add_u32 s16, s16, s40
s_lshl_b32 s40, s29, 4
s_add_u32 s16, s16, s40
v_and_b32 v7, 31, v1
v_lshrrev_b32 v8, 5, v1
v_lshlrev_b32 v4, 4, v7
v_and_b32 v9, 15, v1
v_xor_b32 v9, v9, v8
v_lshlrev_b32 v10, 8, v7
v_lshl_add_u32 v10, v9, 4, v10
v_add_u32 v12, 131072, v10
v_xor_b32 v13, 32, v12
v_xor_b32 v14, 64, v12
v_xor_b32 v15, 96, v12
v_xor_b32 v16, 128, v12
v_xor_b32 v17, 160, v12
v_xor_b32 v18, 192, v12
v_xor_b32 v19, 224, v12
v_lshlrev_b32 v30, 8, v7
v_lshl_add_u32 v30, v8, 3, v30
v_bfe_u32 v9, v1, 2, 2
v_bfe_u32 v10, v1, 4, 1
v_bfe_u32 v11, v1, 1, 1
v_lshl_add_u32 v10, v10, 1, v11
v_xor_b32 v10, s29, v10
v_xor_b32 v11, s3, v9
v_lshl_add_u32 v10, v11, 2, v10
v_lshlrev_b32 v10, 4, v10
v_lshl_add_u32 v10, v9, 8, v10
v_lshl_add_u32 v10, v8, 11, v10
v_and_b32 v11, 1, v1
v_lshl_add_u32 v20, v11, 3, v10
v_add_u32 v21, 0x10000, v20
v_add_u32 v22, 0x20000, v20
v_lshlrev_b32 v29, 4, v1
v_add_u32 v23, 131072, v29
s_lshl_b32 s39, s3, 11
v_add_u32 v24, s39, v23
v_lshlrev_b32 v25, 2, v1
v_add_u32 v25, 128000, v25
s_lshl_b32 s39, s3, 8
v_add_u32 v201, s39, v25
s_lshl_b32 s39, s3, 2
v_add_u32 v202, s39, v31
v_and_b32 v9, 0x13, v7
v_bfe_u32 v10, v7, 2, 1
v_lshl_or_b32 v9, v10, 3, v9
v_bfe_u32 v10, v7, 3, 1
v_lshl_or_b32 v9, v10, 2, v9
v_and_b32 v10, 15, v9
v_xor_b32 v10, v10, v8
v_lshlrev_b32 v9, 8, v9
v_lshl_add_u32 v9, v10, 4, v9
s_lshl_b32 s39, s3, 13
v_add_u32 v9, s39, v9
s_lshl_b32 s43, s3, 3
s_add_u32 s43, s43, 16
s_add_u32 s21, s38, 0x40
v_lshlrev_b32 v203, 3, v1
v_mov_b32 v3, s47
s_waitcnt lgkmcnt(0)
s_mul_i32 s37, s37, 5
s_add_u32 s37, s37, 0x9e3779b1
v_mov_b32 v2, s37
s_and_b32 s17, s37, 0x10001
s_lshr_b32 s18, s37, 1
s_and_b32 s18, s18, 0x10001
s_mov_b32 s76, 0x60006000
s_mov_b32 s77, 0x9ffe9ffe
s_mov_b32 s19, 0xfffefffe
v_mov_b32 v5, s17
v_mov_b32 v6, s18
s_cmp_eq_u32 s3, 0
s_cbranch_scc0 L_nopub
s_lshl_b64 exec, 1, s29
buffer_store_dwordx2 v[2:3], v203, s[24:27], s21 offen
s_mov_b64 exec, -1
L_nopub:
s_cmp_ge_i32 s31, s43
s_cbranch_scc1 L_d2
L_w1:
ds_read_b32 v7, v31
s_waitcnt lgkmcnt(0)
v_readfirstlane_b32 s31, v7
s_cmp_ge_i32 s31, s43
s_cbranch_scc0 L_w1
L_d2:
ds_read_b128 v[32:35], v12
ds_read_b128 v[36:39], v13
ds_read_b128 v[40:43], v14
ds_read_b128 v[44:47], v15
ds_read_b128 v[48:51], v16
ds_read_b128 v[52:55], v17
ds_read_b128 v[56:59], v18
ds_read_b128 v[60:63], v19
v_mov_b32 v12, v9
v_xor_b32 v13, 32, v9
v_xor_b32 v14, 64, v9
v_xor_b32 v15, 96, v9
v_xor_b32 v16, 128, v9
v_xor_b32 v17, 160, v9
v_xor_b32 v18, 192, v9
v_xor_b32 v19, 224, v9
ds_read_b128 v[64:67], v12 offset:0
ds_read_b128 v[68:71], v13 offset:0
ds_read_b128 v[72:75], v14 offset:0
ds_read_b128 v[76:79], v15 offset:0
ds_read_b128 v[80:83], v16 offset:0
ds_read_b128 v[84:87], v17 offset:0
ds_read_b128 v[88:91], v18 offset:0
ds_read_b128 v[92:95], v19 offset:0
s_add_u32 s43, s43, 32
v_mov_b32 v8, 1
s_waitcnt lgkmcnt(7)
v_mfma_f32_32x32x16_bf16 v[96:111], v[64:67], v[32:35], 0
s_waitcnt lgkmcnt(6)
v_mfma_f32_32x32x16_bf16 v[96:111], v[68:71], v[36:39], v[96:111]
s_waitcnt lgkmcnt(5)
v_mfma_f32_32x32x16_bf16 v[96:111], v[72:75], v[40:43], v[96:111]
s_waitcnt lgkmcnt(4)
v_mfma_f32_32x32x16_bf16 v[96:111], v[76:79], v[44:47], v[96:111]
s_waitcnt lgkmcnt(3)
v_mfma_f32_32x32x16_bf16 v[96:111], v[80:83], v[48:51], v[96:111]
s_waitcnt lgkmcnt(2)
v_mfma_f32_32x32x16_bf16 v[96:111], v[84:87], v[52:55], v[96:111]
s_waitcnt lgkmcnt(1)
v_mfma_f32_32x32x16_bf16 v[96:111], v[88:91], v[56:59], v[96:111]
s_waitcnt lgkmcnt(0)
v_mfma_f32_32x32x16_bf16 v[96:111], v[92:95], v[60:63], v[96:111]
ds_write_b32 v202, v8 offset:16
s_nop 3
s_cmp_ge_i32 s31, s43
s_cbranch_scc1 L_d4
L_w3:
ds_read_b32 v7, v31
s_waitcnt lgkmcnt(0)
v_readfirstlane_b32 s31, v7
s_cmp_ge_i32 s31, s43
s_cbranch_scc0 L_w3
L_d4:
ds_read_b128 v[64:67], v12 offset:32768
ds_read_b128 v[68:71], v13 offset:32768
ds_read_b128 v[72:75], v14 offset:32768
ds_read_b128 v[76:79], v15 offset:32768
ds_read_b128 v[80:83], v16 offset:32768
ds_read_b128 v[84:87], v17 offset:32768
ds_read_b128 v[88:91], v18 offset:32768
ds_read_b128 v[92:95], v19 offset:32768
s_add_u32 s43, s43, 32
v_add_u32 v12, 0x10000, v12
v_add_u32 v13, 0x10000, v13
v_add_u32 v14, 0x10000, v14
v_add_u32 v15, 0x10000, v15
v_add_u32 v16, 0x10000, v16
v_add_u32 v17, 0x10000, v17
v_add_u32 v18, 0x10000, v18
v_add_u32 v19, 0x10000, v19
v_max3_f32 v26, v96, v97, v98
v_max_f32 v26, v26, v99
v_max3_f32 v26, v26, v100, v101
v_max3_f32 v26, v26, v102, v103
v_max3_f32 v26, v26, v104, v105
v_max3_f32 v26, v26, v106, v107
v_max3_f32 v26, v26, v108, v109
v_max3_f32 v26, v26, v110, v111
v_mov_b32 v8, 2
s_waitcnt lgkmcnt(7)
v_mfma_f32_32x32x16_bf16 v[112:127], v[64:67], v[32:35], 0
s_waitcnt lgkmcnt(6)
v_mfma_f32_32x32x16_bf16 v[112:127], v[68:71], v[36:39], v[112:127]
s_waitcnt lgkmcnt(5)
v_mfma_f32_32x32x16_bf16 v[112:127], v[72:75], v[40:43], v[112:127]
s_waitcnt lgkmcnt(4)
v_mfma_f32_32x32x16_bf16 v[112:127], v[76:79], v[44:47], v[112:127]
s_waitcnt lgkmcnt(3)
v_mfma_f32_32x32x16_bf16 v[112:127], v[80:83], v[48:51], v[112:127]
s_waitcnt lgkmcnt(2)
v_mfma_f32_32x32x16_bf16 v[112:127], v[84:87], v[52:55], v[112:127]
s_waitcnt lgkmcnt(1)
v_mfma_f32_32x32x16_bf16 v[112:127], v[88:91], v[56:59], v[112:127]
s_waitcnt lgkmcnt(0)
v_mfma_f32_32x32x16_bf16 v[112:127], v[92:95], v[60:63], v[112:127]
ds_write_b32 v202, v8 offset:16
s_nop 3
s_cmp_ge_i32 s31, s43
s_cbranch_scc1 L_d6
L_w5:
ds_read_b32 v7, v31
s_waitcnt lgkmcnt(0)
v_readfirstlane_b32 s31, v7
s_cmp_ge_i32 s31, s43
s_cbranch_scc0 L_w5
L_d6:
ds_read_b128 v[64:67], v12 offset:0
ds_read_b128 v[68:71], v13 offset:0
ds_read_b128 v[72:75], v14 offset:0
ds_read_b128 v[76:79], v15 offset:0
ds_read_b128 v[80:83], v16 offset:0
ds_read_b128 v[84:87], v17 offset:0
ds_read_b128 v[88:91], v18 offset:0
ds_read_b128 v[92:95], v19 offset:0
s_add_u32 s43, s43, 32
s_mov_b32 s39, 0x8000
s_cmp_eq_u32 s3, 3
s_cselect_b32 s39, 49152, s39
v_add_u32 v12, s39, v12
v_add_u32 v13, s39, v13
v_add_u32 v14, s39, v14
v_add_u32 v15, s39, v15
v_add_u32 v16, s39, v16
v_add_u32 v17, s39, v17
v_add_u32 v18, s39, v18
v_add_u32 v19, s39, v19
v_max3_f32 v26, v26, v112, v113
v_max3_f32 v26, v26, v114, v115
v_max3_f32 v26, v26, v116, v117
v_max3_f32 v26, v26, v118, v119
v_max3_f32 v26, v26, v120, v121
v_max3_f32 v26, v26, v122, v123
v_max3_f32 v26, v26, v124, v125
v_max3_f32 v26, v26, v126, v127
v_mov_b32 v8, 3
s_waitcnt lgkmcnt(7)
v_mfma_f32_32x32x16_bf16 v[128:143], v[64:67], v[32:35], 0
s_waitcnt lgkmcnt(6)
v_mfma_f32_32x32x16_bf16 v[128:143], v[68:71], v[36:39], v[128:143]
s_waitcnt lgkmcnt(5)
v_mfma_f32_32x32x16_bf16 v[128:143], v[72:75], v[40:43], v[128:143]
s_waitcnt lgkmcnt(4)
v_mfma_f32_32x32x16_bf16 v[128:143], v[76:79], v[44:47], v[128:143]
s_waitcnt lgkmcnt(3)
v_mfma_f32_32x32x16_bf16 v[128:143], v[80:83], v[48:51], v[128:143]
s_waitcnt lgkmcnt(2)
v_mfma_f32_32x32x16_bf16 v[128:143], v[84:87], v[52:55], v[128:143]
s_waitcnt lgkmcnt(1)
v_mfma_f32_32x32x16_bf16 v[128:143], v[88:91], v[56:59], v[128:143]
s_waitcnt lgkmcnt(0)
v_mfma_f32_32x32x16_bf16 v[128:143], v[92:95], v[60:63], v[128:143]
ds_write_b32 v202, v8 offset:16
s_nop 3
s_cmp_ge_i32 s31, s43
s_cbranch_scc1 L_d8
L_w7:
ds_read_b32 v7, v31
s_waitcnt lgkmcnt(0)
v_readfirstlane_b32 s31, v7
s_cmp_ge_i32 s31, s43
s_cbranch_scc0 L_w7
L_d8:
ds_read_b128 v[64:67], v12 offset:0
ds_read_b128 v[68:71], v13 offset:0
ds_read_b128 v[72:75], v14 offset:0
ds_read_b128 v[76:79], v15 offset:0
ds_read_b128 v[80:83], v16 offset:0
ds_read_b128 v[84:87], v17 offset:0
ds_read_b128 v[88:91], v18 offset:0
ds_read_b128 v[92:95], v19 offset:0
s_add_u32 s43, s43, 32
v_max3_f32 v26, v26, v128, v129
v_max3_f32 v26, v26, v130, v131
v_max3_f32 v26, v26, v132, v133
v_max3_f32 v26, v26, v134, v135
v_max3_f32 v26, v26, v136, v137
v_max3_f32 v26, v26, v138, v139
v_max3_f32 v26, v26, v140, v141
v_max3_f32 v26, v26, v142, v143
v_mov_b32 v8, 4
s_waitcnt lgkmcnt(7)
v_mfma_f32_32x32x16_bf16 v[144:159], v[64:67], v[32:35], 0
s_waitcnt lgkmcnt(6)
v_mfma_f32_32x32x16_bf16 v[144:159], v[68:71], v[36:39], v[144:159]
s_waitcnt lgkmcnt(5)
v_mfma_f32_32x32x16_bf16 v[144:159], v[72:75], v[40:43], v[144:159]
s_waitcnt lgkmcnt(4)
v_mfma_f32_32x32x16_bf16 v[144:159], v[76:79], v[44:47], v[144:159]
s_waitcnt lgkmcnt(3)
v_mfma_f32_32x32x16_bf16 v[144:159], v[80:83], v[48:51], v[144:159]
s_waitcnt lgkmcnt(2)
v_mfma_f32_32x32x16_bf16 v[144:159], v[84:87], v[52:55], v[144:159]
s_waitcnt lgkmcnt(1)
v_mfma_f32_32x32x16_bf16 v[144:159], v[88:91], v[56:59], v[144:159]
s_waitcnt lgkmcnt(0)
v_mfma_f32_32x32x16_bf16 v[144:159], v[92:95], v[60:63], v[144:159]
ds_write_b32 v202, v8 offset:16
s_nop 7
s_nop 3
v_max3_f32 v26, v26, v144, v145
v_max3_f32 v26, v26, v146, v147
v_max3_f32 v26, v26, v148, v149
v_max3_f32 v26, v26, v150, v151
v_max3_f32 v26, v26, v152, v153
v_max3_f32 v26, v26, v154, v155
v_max3_f32 v26, v26, v156, v157
v_max3_f32 v26, v26, v158, v159
v_mov_b32 v7, v26
s_nop 1
v_permlane32_swap_b32 v26, v7
s_nop 1
v_max_f32 v26, v26, v7
ds_write_b32 v201, v26
s_mov_b64 exec, 1
ds_add_u32 v31, v200 offset:32
s_mov_b64 exec, -1
L_c9:
ds_read_b32 v7, v31 offset:32
s_waitcnt lgkmcnt(0)
v_cmp_gt_u32 vcc, 4, v7
s_cbranch_vccnz L_c9
ds_read2st64_b32 v[8:9], v25 offset1:1
ds_read2st64_b32 v[10:11], v25 offset0:2 offset1:3
s_waitcnt lgkmcnt(0)
v_max3_f32 v26, v8, v9, v10
v_max_f32 v26, v26, v11
v_mul_f32 v28, s36, v26
s_load_dwordx8 s[4:11], s[22:23], s21
v_fma_f32 v96, v96, s36, -v28
v_fma_f32 v97, v97, s36, -v28
v_fma_f32 v98, v98, s36, -v28
v_fma_f32 v99, v99, s36, -v28
v_fma_f32 v100, v100, s36, -v28
v_fma_f32 v101, v101, s36, -v28
v_fma_f32 v102, v102, s36, -v28
v_fma_f32 v103, v103, s36, -v28
v_exp_f32 v96, v96
v_exp_f32 v97, v97
v_exp_f32 v98, v98
v_exp_f32 v99, v99
v_exp_f32 v100, v100
v_exp_f32 v101, v101
v_exp_f32 v102, v102
v_exp_f32 v103, v103
v_add_f32 v27, v96, v97
v_add_f32 v7, v98, v99
v_add_f32 v27, v27, v100
v_add_f32 v7, v7, v101
v_add_f32 v27, v27, v102
v_add_f32 v7, v7, v103
v_cvt_pk_bf16_f32 v192, v96, v97
v_cvt_pk_bf16_f32 v193, v98, v99
v_cvt_pk_bf16_f32 v194, v100, v101
v_cvt_pk_bf16_f32 v195, v102, v103
ds_write_b128 v24, v[192:195] offset:0
v_fma_f32 v104, v104, s36, -v28
v_fma_f32 v105, v105, s36, -v28
v_fma_f32 v106, v106, s36, -v28
v_fma_f32 v107, v107, s36, -v28
v_fma_f32 v108, v108, s36, -v28
v_fma_f32 v109, v109, s36, -v28
v_fma_f32 v110, v110, s36, -v28
v_fma_f32 v111, v111, s36, -v28
v_exp_f32 v104, v104
v_exp_f32 v105, v105
v_exp_f32 v106, v106
v_exp_f32 v107, v107
v_exp_f32 v108, v108
v_exp_f32 v109, v109
v_exp_f32 v110, v110
v_exp_f32 v111, v111
v_add_f32 v27, v27, v104
v_add_f32 v7, v7, v105
v_add_f32 v27, v27, v106
v_add_f32 v7, v7, v107
v_add_f32 v27, v27, v108
v_add_f32 v7, v7, v109
v_add_f32 v27, v27, v110
v_add_f32 v7, v7, v111
v_cvt_pk_bf16_f32 v196, v104, v105
v_cvt_pk_bf16_f32 v197, v106, v107
v_cvt_pk_bf16_f32 v198, v108, v109
v_cvt_pk_bf16_f32 v199, v110, v111
ds_write_b128 v24, v[196:199] offset:1024
v_fma_f32 v112, v112, s36, -v28
v_fma_f32 v113, v113, s36, -v28
v_fma_f32 v114, v114, s36, -v28
v_fma_f32 v115, v115, s36, -v28
v_fma_f32 v116, v116, s36, -v28
v_fma_f32 v117, v117, s36, -v28
v_fma_f32 v118, v118, s36, -v28
v_fma_f32 v119, v119, s36, -v28
v_exp_f32 v112, v112
v_exp_f32 v113, v113
v_exp_f32 v114, v114
v_exp_f32 v115, v115
v_exp_f32 v116, v116
v_exp_f32 v117, v117
v_exp_f32 v118, v118
v_exp_f32 v119, v119
v_add_f32 v27, v27, v112
v_add_f32 v7, v7, v113
v_add_f32 v27, v27, v114
v_add_f32 v7, v7, v115
v_add_f32 v27, v27, v116
v_add_f32 v7, v7, v117
v_add_f32 v27, v27, v118
v_add_f32 v7, v7, v119
v_cvt_pk_bf16_f32 v192, v112, v113
v_cvt_pk_bf16_f32 v193, v114, v115
v_cvt_pk_bf16_f32 v194, v116, v117
v_cvt_pk_bf16_f32 v195, v118, v119
ds_write_b128 v24, v[192:195] offset:8192
v_fma_f32 v120, v120, s36, -v28
v_fma_f32 v121, v121, s36, -v28
v_fma_f32 v122, v122, s36, -v28
v_fma_f32 v123, v123, s36, -v28
v_fma_f32 v124, v124, s36, -v28
v_fma_f32 v125, v125, s36, -v28
v_fma_f32 v126, v126, s36, -v28
v_fma_f32 v127, v127, s36, -v28
v_exp_f32 v120, v120
v_exp_f32 v121, v121
v_exp_f32 v122, v122
v_exp_f32 v123, v123
v_exp_f32 v124, v124
v_exp_f32 v125, v125
v_exp_f32 v126, v126
v_exp_f32 v127, v127
v_add_f32 v27, v27, v120
v_add_f32 v7, v7, v121
v_add_f32 v27, v27, v122
v_add_f32 v7, v7, v123
v_add_f32 v27, v27, v124
v_add_f32 v7, v7, v125
v_add_f32 v27, v27, v126
v_add_f32 v7, v7, v127
v_cvt_pk_bf16_f32 v196, v120, v121
v_cvt_pk_bf16_f32 v197, v122, v123
v_cvt_pk_bf16_f32 v198, v124, v125
v_cvt_pk_bf16_f32 v199, v126, v127
ds_write_b128 v24, v[196:199] offset:9216
v_fma_f32 v128, v128, s36, -v28
v_fma_f32 v129, v129, s36, -v28
v_fma_f32 v130, v130, s36, -v28
v_fma_f32 v131, v131, s36, -v28
v_fma_f32 v132, v132, s36, -v28
v_fma_f32 v133, v133, s36, -v28
v_fma_f32 v134, v134, s36, -v28
v_fma_f32 v135, v135, s36, -v28
v_exp_f32 v128, v128
v_exp_f32 v129, v129
v_exp_f32 v130, v130
v_exp_f32 v131, v131
v_exp_f32 v132, v132
v_exp_f32 v133, v133
v_exp_f32 v134, v134
v_exp_f32 v135, v135
v_add_f32 v27, v27, v128
v_add_f32 v7, v7, v129
v_add_f32 v27, v27, v130
v_add_f32 v7, v7, v131
v_add_f32 v27, v27, v132
v_add_f32 v7, v7, v133
v_add_f32 v27, v27, v134
v_add_f32 v7, v7, v135
v_cvt_pk_bf16_f32 v192, v128, v129
v_cvt_pk_bf16_f32 v193, v130, v131
v_cvt_pk_bf16_f32 v194, v132, v133
v_cvt_pk_bf16_f32 v195, v134, v135
ds_write_b128 v24, v[192:195] offset:16384
v_fma_f32 v136, v136, s36, -v28
v_fma_f32 v137, v137, s36, -v28
v_fma_f32 v138, v138, s36, -v28
v_fma_f32 v139, v139, s36, -v28
v_fma_f32 v140, v140, s36, -v28
v_fma_f32 v141, v141, s36, -v28
v_fma_f32 v142, v142, s36, -v28
v_fma_f32 v143, v143, s36, -v28
v_exp_f32 v136, v136
v_exp_f32 v137, v137
v_exp_f32 v138, v138
v_exp_f32 v139, v139
v_exp_f32 v140, v140
v_exp_f32 v141, v141
v_exp_f32 v142, v142
v_exp_f32 v143, v143
v_add_f32 v27, v27, v136
v_add_f32 v7, v7, v137
v_add_f32 v27, v27, v138
v_add_f32 v7, v7, v139
v_add_f32 v27, v27, v140
v_add_f32 v7, v7, v141
v_add_f32 v27, v27, v142
v_add_f32 v7, v7, v143
v_cvt_pk_bf16_f32 v196, v136, v137
v_cvt_pk_bf16_f32 v197, v138, v139
v_cvt_pk_bf16_f32 v198, v140, v141
v_cvt_pk_bf16_f32 v199, v142, v143
ds_write_b128 v24, v[196:199] offset:17408
v_fma_f32 v144, v144, s36, -v28
v_fma_f32 v145, v145, s36, -v28
v_fma_f32 v146, v146, s36, -v28
v_fma_f32 v147, v147, s36, -v28
v_fma_f32 v148, v148, s36, -v28
v_fma_f32 v149, v149, s36, -v28
v_fma_f32 v150, v150, s36, -v28
v_fma_f32 v151, v151, s36, -v28
v_exp_f32 v144, v144
v_exp_f32 v145, v145
v_exp_f32 v146, v146
v_exp_f32 v147, v147
v_exp_f32 v148, v148
v_exp_f32 v149, v149
v_exp_f32 v150, v150
v_exp_f32 v151, v151
v_add_f32 v27, v27, v144
v_add_f32 v7, v7, v145
v_add_f32 v27, v27, v146
v_add_f32 v7, v7, v147
v_add_f32 v27, v27, v148
v_add_f32 v7, v7, v149
v_add_f32 v27, v27, v150
v_add_f32 v7, v7, v151
v_cvt_pk_bf16_f32 v192, v144, v145
v_cvt_pk_bf16_f32 v193, v146, v147
v_cvt_pk_bf16_f32 v194, v148, v149
v_cvt_pk_bf16_f32 v195, v150, v151
ds_write_b128 v24, v[192:195] offset:24576
v_fma_f32 v152, v152, s36, -v28
v_fma_f32 v153, v153, s36, -v28
v_fma_f32 v154, v154, s36, -v28
v_fma_f32 v155, v155, s36, -v28
v_fma_f32 v156, v156, s36, -v28
v_fma_f32 v157, v157, s36, -v28
v_fma_f32 v158, v158, s36, -v28
v_fma_f32 v159, v159, s36, -v28
v_exp_f32 v152, v152
v_exp_f32 v153, v153
v_exp_f32 v154, v154
v_exp_f32 v155, v155
v_exp_f32 v156, v156
v_exp_f32 v157, v157
v_exp_f32 v158, v158
v_exp_f32 v159, v159
v_add_f32 v27, v27, v152
v_add_f32 v7, v7, v153
v_add_f32 v27, v27, v154
v_add_f32 v7, v7, v155
v_add_f32 v27, v27, v156
v_add_f32 v7, v7, v157
v_add_f32 v27, v27, v158
v_add_f32 v7, v7, v159
v_cvt_pk_bf16_f32 v196, v152, v153
v_cvt_pk_bf16_f32 v197, v154, v155
v_cvt_pk_bf16_f32 v198, v156, v157
v_cvt_pk_bf16_f32 v199, v158, v159
ds_write_b128 v24, v[196:199] offset:25600
v_add_f32 v27, v27, v7
v_mov_b32 v7, v27
s_nop 1
v_permlane32_swap_b32 v27, v7
s_nop 1
v_add_f32 v27, v27, v7
ds_write_b32 v201, v27 offset:1024
s_mov_b64 exec, 1
ds_add_u32 v31, v200 offset:36
s_mov_b64 exec, -1
L_c10:
ds_read_b32 v7, v31 offset:36
s_waitcnt lgkmcnt(0)
v_cmp_gt_u32 vcc, 4, v7
s_cbranch_vccnz L_c10
s_mov_b32 s12, s37
s_mov_b32 s13, s47
s_xor_b64 s[4:5], s[4:5], s[12:13]
s_xor_b64 s[6:7], s[6:7], s[12:13]
s_xor_b64 s[8:9], s[8:9], s[12:13]
s_xor_b64 s[10:11], s[10:11], s[12:13]
s_or_b64 s[4:5], s[4:5], s[6:7]
s_or_b64 s[8:9], s[8:9], s[10:11]
s_or_b64 s[4:5], s[4:5], s[8:9]
s_cselect_b32 s46, 0, 1
ds_read2st64_b32 v[8:9], v25 offset0:4 offset1:5
ds_read2st64_b32 v[10:11], v25 offset0:6 offset1:7
ds_read_b128 v[32:35], v23 offset:0
ds_read_b128 v[36:39], v23 offset:1024
ds_read_b128 v[40:43], v23 offset:2048
ds_read_b128 v[44:47], v23 offset:3072
ds_read_b128 v[48:51], v23 offset:4096
ds_read_b128 v[52:55], v23 offset:5120
ds_read_b128 v[56:59], v23 offset:6144
ds_read_b128 v[60:63], v23 offset:7168
s_waitcnt lgkmcnt(4)
s_mov_b64 exec, 1
ds_add_u32 v31, v200 offset:40
s_mov_b64 exec, -1
v_add_f32 v8, v8, v9
v_add_f32 v10, v10, v11
v_add_f32 v27, v8, v10
ds_read_b128 v[64:67], v23 offset:8192
ds_read_b128 v[68:71], v23 offset:9216
ds_read_b128 v[72:75], v23 offset:10240
ds_read_b128 v[76:79], v23 offset:11264
ds_read_b128 v[80:83], v23 offset:12288
ds_read_b128 v[84:87], v23 offset:13312
ds_read_b128 v[88:91], v23 offset:14336
ds_read_b128 v[92:95], v23 offset:15360
s_cmp_eq_u32 s3, 0
s_cbranch_scc0 L_noml
v_mov_b32 v208, v28
v_mov_b32 v209, v27
v_mov_b32 v210, v2
v_mov_b32 v211, v2
s_mov_b32 exec_hi, 0
s_cmp_eq_u32 s46, 0
s_cbranch_scc1 L_mlslow
buffer_store_dwordx4 v[208:211], v4, s[24:27], s68 offen
s_branch L_mlsent
L_mlslow:
buffer_store_dwordx4 v[208:211], v4, s[24:27], s68 offen sc1
L_mlsent:
s_mov_b64 exec, -1
L_noml:
ds_read_b128 v[96:99], v23 offset:16384
ds_read_b128 v[100:103], v23 offset:17408
ds_read_b128 v[104:107], v23 offset:18432
ds_read_b128 v[108:111], v23 offset:19456
ds_read_b128 v[112:115], v23 offset:20480
ds_read_b128 v[116:119], v23 offset:21504
ds_read_b128 v[120:123], v23 offset:22528
ds_read_b128 v[124:127], v23 offset:23552
ds_read_b128 v[128:131], v23 offset:24576
ds_read_b128 v[132:135], v23 offset:25600
ds_read_b128 v[136:139], v23 offset:26624
ds_read_b128 v[140:143], v23 offset:27648
ds_read_b128 v[144:147], v23 offset:28672
ds_read_b128 v[148:151], v23 offset:29696
ds_read_b128 v[152:155], v23 offset:30720
ds_read_b128 v[156:159], v23 offset:31744
s_cmp_ge_i32 s31, 152
s_cbranch_scc1 L_d12
L_w11:
ds_read_b32 v7, v31
s_waitcnt lgkmcnt(0)
v_readfirstlane_b32 s31, v7
s_cmp_ge_i32 s31, 152
s_cbranch_scc0 L_w11
L_d12:
ds_read_b64_tr_b16 v[176:177], v20 offset:0
ds_read_b64_tr_b16 v[178:179], v20 offset:1024
ds_read_b64_tr_b16 v[180:181], v20 offset:4096
ds_read_b64_tr_b16 v[182:183], v20 offset:5120
ds_read_b64_tr_b16 v[184:185], v20 offset:8192
ds_read_b64_tr_b16 v[186:187], v20 offset:9216
ds_read_b64_tr_b16 v[188:189], v20 offset:12288
ds_read_b64_tr_b16 v[190:191], v20 offset:13312
s_waitcnt lgkmcnt(6)
v_mfma_f32_32x32x16_bf16 v[160:175], v[176:179], v[32:35], 0
s_waitcnt lgkmcnt(4)
v_mfma_f32_32x32x16_bf16 v[160:175], v[180:183], v[36:39], v[160:175]
s_waitcnt lgkmcnt(2)
v_mfma_f32_32x32x16_bf16 v[160:175], v[184:187], v[40:43], v[160:175]
s_waitcnt lgkmcnt(0)
v_mfma_f32_32x32x16_bf16 v[160:175], v[188:191], v[44:47], v[160:175]
s_cmp_ge_i32 s31, 168
s_cbranch_scc1 L_d14
L_w13:
ds_read_b32 v7, v31
s_waitcnt lgkmcnt(0)
v_readfirstlane_b32 s31, v7
s_cmp_ge_i32 s31, 168
s_cbranch_scc0 L_w13
L_d14:
ds_read_b64_tr_b16 v[176:177], v20 offset:16384
ds_read_b64_tr_b16 v[178:179], v20 offset:17408
ds_read_b64_tr_b16 v[180:181], v20 offset:20480
ds_read_b64_tr_b16 v[182:183], v20 offset:21504
ds_read_b64_tr_b16 v[184:185], v20 offset:24576
ds_read_b64_tr_b16 v[186:187], v20 offset:25600
ds_read_b64_tr_b16 v[188:189], v20 offset:28672
ds_read_b64_tr_b16 v[190:191], v20 offset:29696
s_waitcnt lgkmcnt(6)
v_mfma_f32_32x32x16_bf16 v[160:175], v[176:179], v[48:51], v[160:175]
s_waitcnt lgkmcnt(4)
v_mfma_f32_32x32x16_bf16 v[160:175], v[180:183], v[52:55], v[160:175]
s_waitcnt lgkmcnt(2)
v_mfma_f32_32x32x16_bf16 v[160:175], v[184:187], v[56:59], v[160:175]
s_waitcnt lgkmcnt(0)
v_mfma_f32_32x32x16_bf16 v[160:175], v[188:191], v[60:63], v[160:175]
s_cmp_ge_i32 s31, 184
s_cbranch_scc1 L_d16
L_w15:
ds_read_b32 v7, v31
s_waitcnt lgkmcnt(0)
v_readfirstlane_b32 s31, v7
s_cmp_ge_i32 s31, 184
s_cbranch_scc0 L_w15
L_d16:
ds_read_b64_tr_b16 v[176:177], v20 offset:32768
ds_read_b64_tr_b16 v[178:179], v20 offset:33792
ds_read_b64_tr_b16 v[180:181], v20 offset:36864
ds_read_b64_tr_b16 v[182:183], v20 offset:37888
ds_read_b64_tr_b16 v[184:185], v20 offset:40960
ds_read_b64_tr_b16 v[186:187], v20 offset:41984
ds_read_b64_tr_b16 v[188:189], v20 offset:45056
ds_read_b64_tr_b16 v[190:191], v20 offset:46080
s_waitcnt lgkmcnt(6)
v_mfma_f32_32x32x16_bf16 v[160:175], v[176:179], v[64:67], v[160:175]
s_waitcnt lgkmcnt(4)
v_mfma_f32_32x32x16_bf16 v[160:175], v[180:183], v[68:71], v[160:175]
s_waitcnt lgkmcnt(2)
v_mfma_f32_32x32x16_bf16 v[160:175], v[184:187], v[72:75], v[160:175]
s_waitcnt lgkmcnt(0)
v_mfma_f32_32x32x16_bf16 v[160:175], v[188:191], v[76:79], v[160:175]
s_cmp_ge_i32 s31, 200
s_cbranch_scc1 L_d18
L_w17:
ds_read_b32 v7, v31
s_waitcnt lgkmcnt(0)
v_readfirstlane_b32 s31, v7
s_cmp_ge_i32 s31, 200
s_cbranch_scc0 L_w17
L_d18:
ds_read_b64_tr_b16 v[176:177], v20 offset:49152
ds_read_b64_tr_b16 v[178:179], v20 offset:50176
ds_read_b64_tr_b16 v[180:181], v20 offset:53248
ds_read_b64_tr_b16 v[182:183], v20 offset:54272
ds_read_b64_tr_b16 v[184:185], v20 offset:57344
ds_read_b64_tr_b16 v[186:187], v20 offset:58368
ds_read_b64_tr_b16 v[188:189], v20 offset:61440
ds_read_b64_tr_b16 v[190:191], v20 offset:62464
s_waitcnt lgkmcnt(6)
v_mfma_f32_32x32x16_bf16 v[160:175], v[176:179], v[80:83], v[160:175]
s_waitcnt lgkmcnt(4)
v_mfma_f32_32x32x16_bf16 v[160:175], v[180:183], v[84:87], v[160:175]
s_waitcnt lgkmcnt(2)
v_mfma_f32_32x32x16_bf16 v[160:175], v[184:187], v[88:91], v[160:175]
s_waitcnt lgkmcnt(0)
v_mfma_f32_32x32x16_bf16 v[160:175], v[188:191], v[92:95], v[160:175]
buffer_load_dwordx3 v[212:214], v4, s[24:27], s69 offen sc1
buffer_load_dwordx3 v[216:218], v4, s[24:27], s70 offen sc1
buffer_load_dwordx3 v[220:222], v4, s[24:27], s71 offen sc1
s_cmp_ge_i32 s31, 216
s_cbranch_scc1 L_d20
L_w19:
ds_read_b32 v7, v31
s_waitcnt lgkmcnt(0)
v_readfirstlane_b32 s31, v7
s_cmp_ge_i32 s31, 216
s_cbranch_scc0 L_w19
L_d20:
ds_read_b64_tr_b16 v[176:177], v21 offset:0
ds_read_b64_tr_b16 v[178:179], v21 offset:1024
ds_read_b64_tr_b16 v[180:181], v21 offset:4096
ds_read_b64_tr_b16 v[182:183], v21 offset:5120
ds_read_b64_tr_b16 v[184:185], v21 offset:8192
ds_read_b64_tr_b16 v[186:187], v21 offset:9216
ds_read_b64_tr_b16 v[188:189], v21 offset:12288
ds_read_b64_tr_b16 v[190:191], v21 offset:13312
s_waitcnt lgkmcnt(6)
v_mfma_f32_32x32x16_bf16 v[160:175], v[176:179], v[96:99], v[160:175]
s_waitcnt lgkmcnt(4)
v_mfma_f32_32x32x16_bf16 v[160:175], v[180:183], v[100:103], v[160:175]
s_waitcnt lgkmcnt(2)
v_mfma_f32_32x32x16_bf16 v[160:175], v[184:187], v[104:107], v[160:175]
s_waitcnt lgkmcnt(0)
v_mfma_f32_32x32x16_bf16 v[160:175], v[188:191], v[108:111], v[160:175]
s_cmp_ge_i32 s31, 224
s_cbranch_scc1 L_d22
L_w21:
ds_read_b32 v7, v31
s_waitcnt lgkmcnt(0)
v_readfirstlane_b32 s31, v7
s_cmp_ge_i32 s31, 224
s_cbranch_scc0 L_w21
L_d22:
ds_read_b64_tr_b16 v[176:177], v21 offset:16384
ds_read_b64_tr_b16 v[178:179], v21 offset:17408
ds_read_b64_tr_b16 v[180:181], v21 offset:20480
ds_read_b64_tr_b16 v[182:183], v21 offset:21504
s_waitcnt lgkmcnt(2)
v_mfma_f32_32x32x16_bf16 v[160:175], v[176:179], v[112:115], v[160:175]
s_waitcnt lgkmcnt(0)
v_mfma_f32_32x32x16_bf16 v[160:175], v[180:183], v[116:119], v[160:175]
s_cmp_ge_i32 s31, 232
s_cbranch_scc1 L_d24
L_w23:
ds_read_b32 v7, v31
s_waitcnt lgkmcnt(0)
v_readfirstlane_b32 s31, v7
s_cmp_ge_i32 s31, 232
s_cbranch_scc0 L_w23
L_d24:
ds_read_b64_tr_b16 v[176:177], v21 offset:24576
ds_read_b64_tr_b16 v[178:179], v21 offset:25600
ds_read_b64_tr_b16 v[180:181], v21 offset:28672
ds_read_b64_tr_b16 v[182:183], v21 offset:29696
s_waitcnt lgkmcnt(2)
v_mfma_f32_32x32x16_bf16 v[160:175], v[176:179], v[120:123], v[160:175]
s_waitcnt lgkmcnt(0)
v_mfma_f32_32x32x16_bf16 v[160:175], v[180:183], v[124:127], v[160:175]
s_cmp_ge_i32 s31, 240
s_cbranch_scc1 L_d26
L_w25:
ds_read_b32 v7, v31
s_waitcnt lgkmcnt(0)
v_readfirstlane_b32 s31, v7
s_cmp_ge_i32 s31, 240
s_cbranch_scc0 L_w25
L_d26:
ds_read_b64_tr_b16 v[176:177], v21 offset:32768
ds_read_b64_tr_b16 v[178:179], v21 offset:33792
ds_read_b64_tr_b16 v[180:181], v21 offset:36864
ds_read_b64_tr_b16 v[182:183], v21 offset:37888
buffer_load_dwordx2 v[228:229], v203, s[24:27], s41 offen offset:512
buffer_load_dwordx2 v[232:233], v203, s[24:27], s41 offen offset:1024
buffer_load_dwordx2 v[236:237], v203, s[24:27], s41 offen offset:1536
s_waitcnt lgkmcnt(2)
v_mfma_f32_32x32x16_bf16 v[160:175], v[176:179], v[128:131], v[160:175]
s_waitcnt lgkmcnt(0)
v_mfma_f32_32x32x16_bf16 v[160:175], v[180:183], v[132:135], v[160:175]
s_cmp_ge_i32 s31, 248
s_cbranch_scc1 L_d28
L_w27:
ds_read_b32 v7, v31
s_waitcnt lgkmcnt(0)
v_readfirstlane_b32 s31, v7
s_cmp_ge_i32 s31, 248
s_cbranch_scc0 L_w27
L_d28:
ds_read_b64_tr_b16 v[176:177], v21 offset:40960
ds_read_b64_tr_b16 v[178:179], v21 offset:41984
ds_read_b64_tr_b16 v[180:181], v21 offset:45056
ds_read_b64_tr_b16 v[182:183], v21 offset:46080
s_waitcnt lgkmcnt(2)
v_mfma_f32_32x32x16_bf16 v[160:175], v[176:179], v[136:139], v[160:175]
s_waitcnt lgkmcnt(0)
v_mfma_f32_32x32x16_bf16 v[160:175], v[180:183], v[140:143], v[160:175]
s_cmp_ge_i32 s31, 256
s_cbranch_scc1 L_d30
L_w29:
ds_read_b32 v7, v31
s_waitcnt lgkmcnt(0)
v_readfirstlane_b32 s31, v7
s_cmp_ge_i32 s31, 256
s_cbranch_scc0 L_w29
L_d30:
ds_read_b64_tr_b16 v[176:177], v21 offset:49152
ds_read_b64_tr_b16 v[178:179], v21 offset:50176
ds_read_b64_tr_b16 v[180:181], v21 offset:53248
ds_read_b64_tr_b16 v[182:183], v21 offset:54272
s_waitcnt lgkmcnt(2)
v_mfma_f32_32x32x16_bf16 v[160:175], v[176:179], v[144:147], v[160:175]
s_waitcnt lgkmcnt(0)
v_mfma_f32_32x32x16_bf16 v[160:175], v[180:183], v[148:151], v[160:175]
s_barrier
ds_read_b64_tr_b16 v[176:177], v21 offset:57344
ds_read_b64_tr_b16 v[178:179], v21 offset:58368
s_waitcnt lgkmcnt(0)
v_mfma_f32_32x32x16_bf16 v[160:175], v[176:179], v[152:155], v[160:175]
s_barrier
ds_read_b64_tr_b16 v[176:177], v22 offset:0
ds_read_b64_tr_b16 v[178:179], v22 offset:1024
s_waitcnt lgkmcnt(0)
v_mfma_f32_32x32x16_bf16 v[160:175], v[176:179], v[156:159], v[160:175]
s_mov_b32 s42, 0x100000
s_cmp_eq_u32 s46, 0
s_nop 9
v_max3_f32 v183, |v164|, |v165|, |v166|
v_max3_f32 v184, |v167|, |v168|, |v169|
v_max3_f32 v182, |v170|, |v171|, |v172|
v_max3_f32 v183, v183, |v173|, |v174|
v_max3_f32 v184, v184, v182, |v175|
v_max_f32 v183, v183, v184
v_lshrrev_b32 v176, 23, v183
v_sub_u32 v178, 0x76, v176
v_lshlrev_b32 v180, 11, v176
v_ldexp_f32 v178, 1.0, v178
v_lshl_or_b32 v180, v176, 23, v180
v_lshlrev_b32 v181, 2, v180
v_and_or_b32 v180, v180, s76, v5
v_and_or_b32 v181, v181, s76, v6
v_pk_mul_f32 v[164:165], v[164:165], v[178:179] op_sel_hi:[1,0]
v_pk_mul_f32 v[166:167], v[166:167], v[178:179] op_sel_hi:[1,0]
v_pk_mul_f32 v[168:169], v[168:169], v[178:179] op_sel_hi:[1,0]
v_pk_mul_f32 v[170:171], v[170:171], v[178:179] op_sel_hi:[1,0]
v_pk_mul_f32 v[172:173], v[172:173], v[178:179] op_sel_hi:[1,0]
v_pk_mul_f32 v[174:175], v[174:175], v[178:179] op_sel_hi:[1,0]
v_cvt_pk_f16_f32 v164, v164, v165
v_cvt_pk_f16_f32 v165, v166, v167
v_cvt_pk_f16_f32 v168, v168, v169
v_cvt_pk_f16_f32 v169, v170, v171
v_cvt_pk_f16_f32 v172, v172, v173
v_cvt_pk_f16_f32 v173, v174, v175
s_cbranch_scc1 L_sendslow
v_and_or_b32 v164, v164, s19, v180
v_and_or_b32 v165, v165, s19, v181
buffer_store_dwordx2 v[164:165], v203, s[24:27], s65 offen offset:512
v_and_or_b32 v168, v168, s19, v180
v_and_or_b32 v169, v169, s19, v181
buffer_store_dwordx2 v[168:169], v203, s[24:27], s66 offen offset:1024
v_and_or_b32 v172, v172, s19, v180
v_and_or_b32 v173, v173, s19, v181
buffer_store_dwordx2 v[172:173], v203, s[24:27], s67 offen offset:1536
L_sent:
buffer_load_dwordx2 v[228:229], v203, s[24:27], s41 offen offset:512 sc1
buffer_load_dwordx2 v[232:233], v203, s[24:27], s41 offen offset:1024 sc1
buffer_load_dwordx2 v[236:237], v203, s[24:27], s41 offen offset:1536 sc1
s_mov_b32 s42, 0x100000
s_waitcnt vmcnt(9)
s_branch L_mlchk
L_mlpoll:
buffer_load_dwordx3 v[212:214], v4, s[24:27], s69 offen sc1
buffer_load_dwordx3 v[216:218], v4, s[24:27], s70 offen sc1
buffer_load_dwordx3 v[220:222], v4, s[24:27], s71 offen sc1
s_waitcnt vmcnt(0)
L_mlchk:
s_sub_u32 s42, s42, 1
v_xor_b32 v7, v2, v214
v_bitop3_b32 v7, v7, v218, v2 bitop3:0xf6
v_bitop3_b32 v7, v7, v222, v2 bitop3:0xf6
v_cmp_ne_u32 vcc, 0, v7
s_cbranch_scc1 L_mlgot
s_cbranch_vccnz L_mlpoll
L_mlgot:
v_max3_f32 v26, v28, v212, v216
v_max_f32 v26, v26, v220
v_sub_f32 v28, v28, v26
v_sub_f32 v212, v212, v26
v_sub_f32 v216, v216, v26
v_sub_f32 v220, v220, v26
v_exp_f32 v28, v28
v_exp_f32 v212, v212
v_exp_f32 v216, v216
v_exp_f32 v220, v220
v_mul_f32 v8, v28, v27
v_fmac_f32 v8, v212, v213
v_fmac_f32 v8, v216, v217
v_fmac_f32 v8, v220, v221
v_rcp_f32 v8, v8
s_nop 0
v_mul_f32 v204, v28, v8
v_mul_f32 v205, v212, v8
v_mul_f32 v206, v216, v8
v_mul_f32 v207, v220, v8
s_or_b32 s39, s29, s3
s_cbranch_scc1 L_noep
v_mov_b32 v8, 0
s_mov_b64 exec, 1
buffer_store_dword v2, v8, s[24:27], s38 offen
s_mov_b64 exec, -1
L_noep:
s_mov_b32 s42, 0x100000
v_pk_mul_f32 v[224:225], v[160:161], v[204:205] op_sel_hi:[1,0]
v_pk_mul_f32 v[226:227], v[162:163], v[204:205] op_sel_hi:[1,0]
s_branch L_chk
L_poll:
buffer_load_dwordx2 v[228:229], v203, s[24:27], s41 offen offset:512 sc1
buffer_load_dwordx2 v[232:233], v203, s[24:27], s41 offen offset:1024 sc1
buffer_load_dwordx2 v[236:237], v203, s[24:27], s41 offen offset:1536 sc1
L_chk:
s_sub_u32 s42, s42, 1
s_waitcnt vmcnt(2)
v_xor_b32 v7, s17, v228
v_bitop3_b32 v7, v7, v229, s18 bitop3:0xf6
s_waitcnt vmcnt(1)
v_bitop3_b32 v7, v7, v232, s17 bitop3:0xf6
v_bitop3_b32 v7, v7, v233, s18 bitop3:0xf6
s_waitcnt vmcnt(0)
v_bitop3_b32 v7, v7, v236, s17 bitop3:0xf6
v_bitop3_b32 v7, v7, v237, s18 bitop3:0xf6
v_and_b32 v7, 0x10001, v7
v_lshrrev_b32 v230, 2, v229
v_cmp_ne_u32 vcc, 0, v7
v_lshrrev_b32 v234, 2, v233
s_cbranch_scc1 L_math
s_cbranch_vccnz L_poll
L_math:
v_lshrrev_b32 v238, 2, v237
v_bfi_b32 v230, s76, v228, v230
v_bfi_b32 v234, s76, v232, v234
v_bfi_b32 v238, s76, v236, v238
v_and_b32 v228, s77, v228
v_and_b32 v232, s77, v232
v_and_b32 v236, s77, v236
v_and_b32 v229, s77, v229
v_and_b32 v233, s77, v233
v_and_b32 v237, s77, v237
v_bfe_u32 v231, v230, 27, 4
v_bfe_u32 v235, v234, 27, 4
v_bfe_u32 v239, v238, 27, 4
v_bfe_u32 v230, v230, 11, 4
v_bfe_u32 v234, v234, 11, 4
v_bfe_u32 v238, v238, 11, 4
v_lshl_or_b32 v230, v231, 4, v230
v_lshl_or_b32 v234, v235, 4, v234
v_lshl_or_b32 v238, v239, 4, v238
v_subrev_u32 v230, 0x76, v230
v_subrev_u32 v234, 0x76, v234
v_subrev_u32 v238, 0x76, v238
v_ldexp_f32 v230, v205, v230
v_ldexp_f32 v234, v206, v234
v_ldexp_f32 v238, v207, v238
v_fma_mix_f32 v224, v228, v230, v224 op_sel_hi:[1,0,0]
v_fma_mix_f32 v225, v228, v230, v225 op_sel:[1,0,0] op_sel_hi:[1,0,0]
v_fma_mix_f32 v226, v229, v230, v226 op_sel_hi:[1,0,0]
v_fma_mix_f32 v227, v229, v230, v227 op_sel:[1,0,0] op_sel_hi:[1,0,0]
v_fma_mix_f32 v224, v232, v234, v224 op_sel_hi:[1,0,0]
v_fma_mix_f32 v225, v232, v234, v225 op_sel:[1,0,0] op_sel_hi:[1,0,0]
v_fma_mix_f32 v226, v233, v234, v226 op_sel_hi:[1,0,0]
v_fma_mix_f32 v227, v233, v234, v227 op_sel:[1,0,0] op_sel_hi:[1,0,0]
v_fma_mix_f32 v224, v236, v238, v224 op_sel_hi:[1,0,0]
v_fma_mix_f32 v225, v236, v238, v225 op_sel:[1,0,0] op_sel_hi:[1,0,0]
v_fma_mix_f32 v226, v237, v238, v226 op_sel_hi:[1,0,0]
v_fma_mix_f32 v227, v237, v238, v227 op_sel:[1,0,0] op_sel_hi:[1,0,0]
v_cvt_pk_bf16_f32 v192, v224, v225
v_cvt_pk_bf16_f32 v193, v226, v227
L_got:
buffer_store_dwordx2 v[192:193], v30, s[32:35], s16 offen
L_fin:
L_end:
s_endpgm
L_sendslow:
v_and_or_b32 v164, v164, s19, v180
v_and_or_b32 v165, v165, s19, v181
buffer_store_dwordx2 v[164:165], v203, s[24:27], s65 offen offset:512 sc1
v_and_or_b32 v168, v168, s19, v180
v_and_or_b32 v169, v169, s19, v181
buffer_store_dwordx2 v[168:169], v203, s[24:27], s66 offen offset:1024 sc1
v_and_or_b32 v172, v172, s19, v180
v_and_or_b32 v173, v173, s19, v181
buffer_store_dwordx2 v[172:173], v203, s[24:27], s67 offen offset:1536 sc1
s_branch L_sent
L_codeend:
.section .rodata,"a"
.p2align 6
.amdhsa_kernel standalone__gqa_softmax__sampling_kernel
  .amdhsa_next_free_vgpr 252
  .amdhsa_next_free_sgpr 80
  .amdhsa_accum_offset 252
  .amdhsa_group_segment_fixed_size 0
  .amdhsa_kernarg_size 48
  .amdhsa_user_sgpr_count 2
  .amdhsa_user_sgpr_kernarg_segment_ptr 1
  .amdhsa_system_sgpr_workgroup_id_x 1
  .amdhsa_float_denorm_mode_32 3
.end_amdhsa_kernel
```
